```python
import torch

def _softmax(x, axis=-1):
    return torch.softmax(x, dim=axis)
def _gelu(x):
    return torch.nn.functional.gelu(x, approximate="tanh")
def _silu(x):
    return torch.nn.functional.silu(x)
def _sigmoid(x):
    return torch.sigmoid(x)
def _layernorm(x, axis=-1, eps=1e-5):
    m = x.mean(dim=axis, keepdim=True)
    v = x.var(dim=axis, keepdim=True, unbiased=False)
    return (x - m) / torch.sqrt(v + eps)
def _scatter_add(tgt, idx, src, axis=0):
    return tgt.clone().index_add_(axis, idx, src)
def _segment_sum(src, seg, n):
    out = torch.zeros((n,) + src.shape[1:], dtype=src.dtype)
    return out.index_add_(0, seg, src)
def _pad(x, pw):
    flat = tuple(v for pair in reversed(pw) for v in pair)
    return torch.nn.functional.pad(x, flat)

kernel_name = 'standalone__softmax_full_bidir__sampling'

def setup_inputs():

    _w = (lambda a: (lambda t: t.to(torch.bfloat16) if t.is_floating_point() else t)(torch.as_tensor(a)))
    B, H, Sq, Skv, Dh = 8, 16, 16, 2048, 256
    return {
        "q": _w((lambda *s: torch.randn(*s, dtype=torch.bfloat16) * 0.8)(B, H, Sq, Dh)),
        "k": _w((lambda *s: torch.randn(*s, dtype=torch.bfloat16) * 0.8)(B, H, Skv, Dh)),
        "v": _w((lambda *s: torch.randn(*s, dtype=torch.bfloat16) * 0.05)(B, H, Skv, Dh)),
    }

def reference(q, k, v):
    scale = q.shape[-1] ** -0.5
    scores = torch.einsum('bhqd,bhkd->bhqk', q, k) * scale
    attn = _softmax(scores, axis=-1)
    return torch.einsum('bhqk,bhkd->bhqd', attn, v)
```

```asm
; @launch grid=(256,1,1) block=(512,1,1) lds=160768
.amdgcn_target "amdgcn-amd-amdhsa--gfx950"
.text
.globl standalone__softmax_full_bidir__sampling_kernel
.p2align 8
.type standalone__softmax_full_bidir__sampling_kernel,@function
standalone__softmax_full_bidir__sampling_kernel:
    s_load_dwordx2 s[16:17], s[0:1], 8
    s_load_dwordx2 s[24:25], s[0:1], 0
    v_readfirstlane_b32 s40, v0
    s_cmpk_ge_u32 s2, 0x100
    s_cbranch_scc1 L_end
    s_getpc_b64 s[64:65]
L_pc:
    v_lshlrev_b32 v64, 4, v0
    v_mov_b32 v65, 0
    v_add_u32 v66, 0x2000, v64
    v_mov_b32 v67, 0
    v_min_u32 v66, L_end-L_pc-16, v66
    v_lshl_add_u64 v[64:65], v[64:65], 0, s[64:65]
    v_lshl_add_u64 v[66:67], v[66:67], 0, s[64:65]
    global_load_dwordx4 v[208:211], v[64:65], off
    global_load_dwordx4 v[212:215], v[66:67], off
    s_and_b32 s54, s2, 3
    s_lshl_b32 s54, s54, 22
    s_and_b32 s45, s2, 4
    s_lshl_b32 s45, s45, 24
    s_or_b32 s54, s54, s45
    s_and_b32 s45, s2, 56
    s_lshl_b32 s45, s45, 16
    s_or_b32 s54, s54, s45
    s_lshr_b32 s45, s2, 6
    s_lshl_b32 s45, s45, 24
    s_or_b32 s54, s54, s45
    v_and_b32 v1, 63, v0
    s_lshl_b32 s43, s40, 6
    v_lshlrev_b32 v202, 4, v1
    s_mov_b32 m0, s43
    v_lshrrev_b32 v22, 1, v0
    s_or_b32 s44, s54, s43
    v_and_b32 v22, 16, v22
    s_and_b32 s45, s40, 64
    v_xor_b32 v24, v22, v202
    s_lshl_b32 s46, s45, 1
    s_lshl_b32 s45, s45, 11
    v_xor_b32 v2, s46, v24
    s_or_b32 s44, s44, s45
    s_lshr_b32 s48, s40, 8
    s_lshl_b32 s45, s48, 18
    s_brev_b32 s18, 16
    s_mov_b32 s19, 0x20000
    s_or_b32 s63, s44, s45
    v_xor_b32 v3, 32, v2
    v_xor_b32 v4, 64, v2
    v_xor_b32 v5, 32, v4
    s_waitcnt lgkmcnt(0)
    buffer_load_dwordx4 v2, s[16:19], s63 offen offset:0 nt lds
    buffer_load_dwordx4 v3, s[16:19], s63 offen offset:1024 nt lds
    buffer_load_dwordx4 v4, s[16:19], s63 offen offset:2048 nt lds
    buffer_load_dwordx4 v5, s[16:19], s63 offen offset:3072 nt lds
    s_load_dwordx2 s[20:21], s[0:1], 16
    s_load_dwordx2 s[28:29], s[0:1], 24
    s_load_dwordx2 s[32:33], s[0:1], 40
    s_lshr_b32 s41, s54, 20
    s_bfe_u32 s42, s54, 0x10013
    s_lshr_b32 s40, s40, 6
    s_lshl_b32 s46, s40, 5
    v_xor_b32 v26, s46, v24
    s_lshl_b32 s52, s41, 13
    s_lshl_b32 s53, s40, 10
    s_add_u32 m0, s53, 131072
    s_add_u32 s53, s53, s52
    s_mov_b32 s26, 0x100000
    s_mov_b32 s27, 0x20000
    buffer_load_dwordx4 v26, s[24:27], s53 offen nt lds
    s_barrier
    s_add_u32 m0, s43, 65536
    s_xor_b32 s44, s63, 32768
    buffer_load_dwordx4 v2, s[16:19], s44 offen offset:0 nt lds
    buffer_load_dwordx4 v3, s[16:19], s44 offen offset:1024 nt lds
    buffer_load_dwordx4 v4, s[16:19], s44 offen offset:2048 nt lds
    buffer_load_dwordx4 v5, s[16:19], s44 offen offset:3072 nt lds
    s_barrier
    s_add_u32 m0, s43, 32768
    s_xor_b32 s44, s63, 65536
    buffer_load_dwordx4 v2, s[16:19], s44 offen offset:0 nt lds
    buffer_load_dwordx4 v3, s[16:19], s44 offen offset:1024 nt lds
    buffer_load_dwordx4 v4, s[16:19], s44 offen offset:2048 nt lds
    buffer_load_dwordx4 v5, s[16:19], s44 offen offset:3072 nt lds
    s_brev_b32 s22, 16
    s_mov_b32 s23, 0x20000
    s_mov_b32 s30, 0x100000
    s_mov_b32 s31, 0x20000
    s_mov_b32 s34, 2244608
    s_mov_b32 s35, 0x20000
    s_mul_i32 s45, s41, 17536
    s_mul_i32 s58, s40, 2176
    s_add_u32 s58, s58, s45
    s_add_u32 s59, s45, 17408
    s_mov_b32 s47, 0x3db8aa3b
    s_cmp_eq_u32 s40, 0
    s_cselect_b32 s61, s42, 0
    v_mov_b32 v197, 0
    v_lshlrev_b32 v25, 1, v22
    v_xor_b32 v6, v25, v202
    v_xor_b32 v7, 64, v6
    v_xor_b32 v8, 128, v6
    v_xor_b32 v9, 192, v6
    v_and_b32 v27, 15, v1
    v_lshrrev_b32 v28, 4, v1
    v_xor_b32 v29, v27, v28
    v_lshlrev_b32 v29, 4, v29
    v_lshl_add_u32 v29, v27, 9, v29
    s_and_b32 s45, s40, 3
    s_lshl_b32 s45, s45, 13
    s_lshl_b32 s46, s48, 16
    s_add_u32 s45, s45, s46
    v_xor_b32 v144, 0, v29
    v_add_u32 v10, s45, v144
    v_add_u32 v144, 131072, v144
    v_xor_b32 v145, 64, v29
    v_add_u32 v11, s45, v145
    v_add_u32 v145, 131072, v145
    v_xor_b32 v146, 128, v29
    v_add_u32 v12, s45, v146
    v_add_u32 v146, 131072, v146
    v_xor_b32 v147, 192, v29
    v_add_u32 v13, s45, v147
    v_add_u32 v147, 131072, v147
    v_lshrrev_b32 v29, 2, v1
    v_and_b32 v30, 7, v29
    v_lshlrev_b32 v30, 1, v30
    v_bfe_u32 v31, v1, 1, 1
    s_lshl_b32 s45, s40, 2
    v_or_b32 v31, s45, v31
    v_xor_b32 v30, v30, v31
    v_lshlrev_b32 v30, 4, v30
    v_lshl_add_u32 v30, v29, 9, v30
    v_and_b32 v31, 1, v1
    v_lshl_add_u32 v14, v31, 3, v30
    v_xor_b32 v15, 32, v14
    v_add_u32 v16, 0x10000, v14
    v_add_u32 v17, 0x10000, v15
    v_add_u32 v18, 131072, v202
    v_lshlrev_b32 v21, 5, v27
    v_add_u32 v21, 159744, v21
    v_add_u32 v20, s45, v21
    s_lshl_b32 s45, s48, 11
    s_bfe_u32 s46, s40, 0x10001
    s_lshl_b32 s46, s46, 10
    s_add_u32 s45, s45, s46
    s_and_b32 s46, s40, 1
    s_lshl_b32 s46, s46, 3
    s_add_u32 s45, s45, s46
    v_add_u32 v19, s45, v18
    v_lshlrev_b32 v204, 3, v27
    v_lshlrev_b32 v203, 9, v27
    v_lshl_add_u32 v203, v28, 3, v203
    s_lshl_b32 s45, s40, 6
    v_add_u32 v203, s45, v203
    v_mov_b32 v176, 0
    v_mov_b32 v177, 0
    v_mov_b32 v178, 0
    v_mov_b32 v179, 0
    v_mov_b32 v180, 0
    v_mov_b32 v181, 0
    v_mov_b32 v182, 0
    v_mov_b32 v183, 0
    s_waitcnt vmcnt(8) lgkmcnt(0)
    s_barrier
    ds_read_b128 v[32:35], v144 offset:0
    ds_read_b128 v[36:39], v145 offset:0
    ds_read_b128 v[40:43], v146 offset:0
    ds_read_b128 v[44:47], v147 offset:0
    ds_read_b128 v[48:51], v144 offset:256
    ds_read_b128 v[52:55], v145 offset:256
    ds_read_b128 v[56:59], v146 offset:256
    ds_read_b128 v[60:63], v147 offset:256
    s_cmp_lg_u32 s48, 0
    s_cbranch_scc1 L_kskip0
    ds_read_b128 v[64:67], v10 offset:0
    ds_read_b128 v[68:71], v11 offset:0
    ds_read_b128 v[72:75], v12 offset:0
    ds_read_b128 v[76:79], v13 offset:0
    ds_read_b128 v[80:83], v10 offset:256
    ds_read_b128 v[84:87], v11 offset:256
    ds_read_b128 v[88:91], v12 offset:256
    ds_read_b128 v[92:95], v13 offset:256
    s_waitcnt lgkmcnt(7)
    v_mfma_f32_16x16x32_bf16 v[96:99], v[64:67], v[32:35], 0
    s_waitcnt lgkmcnt(6)
    v_mfma_f32_16x16x32_bf16 v[96:99], v[68:71], v[36:39], v[96:99]
    s_waitcnt lgkmcnt(5)
    v_mfma_f32_16x16x32_bf16 v[96:99], v[72:75], v[40:43], v[96:99]
    s_waitcnt lgkmcnt(4)
    v_mfma_f32_16x16x32_bf16 v[96:99], v[76:79], v[44:47], v[96:99]
    s_waitcnt lgkmcnt(3)
    v_mfma_f32_16x16x32_bf16 v[96:99], v[80:83], v[48:51], v[96:99]
    s_waitcnt lgkmcnt(2)
    v_mfma_f32_16x16x32_bf16 v[96:99], v[84:87], v[52:55], v[96:99]
    s_waitcnt lgkmcnt(1)
    v_mfma_f32_16x16x32_bf16 v[96:99], v[88:91], v[56:59], v[96:99]
    s_waitcnt lgkmcnt(0)
    v_mfma_f32_16x16x32_bf16 v[96:99], v[92:95], v[60:63], v[96:99]
L_kskip0:
    s_waitcnt lgkmcnt(0)
    s_waitcnt vmcnt(4)
    s_barrier
    s_add_u32 m0, s43, 98304
    s_xor_b32 s44, s63, 98304
    buffer_load_dwordx4 v2, s[16:19], s44 offen offset:0 nt lds
    buffer_load_dwordx4 v3, s[16:19], s44 offen offset:1024 nt lds
    buffer_load_dwordx4 v4, s[16:19], s44 offen offset:2048 nt lds
    buffer_load_dwordx4 v5, s[16:19], s44 offen offset:3072 nt lds
    s_cmp_lg_u32 s48, 1
    s_cbranch_scc1 L_kskip1
    ds_read_b128 v[64:67], v10 offset:0
    ds_read_b128 v[68:71], v11 offset:0
    ds_read_b128 v[72:75], v12 offset:0
    ds_read_b128 v[76:79], v13 offset:0
    ds_read_b128 v[80:83], v10 offset:256
    ds_read_b128 v[84:87], v11 offset:256
    ds_read_b128 v[88:91], v12 offset:256
    ds_read_b128 v[92:95], v13 offset:256
    s_waitcnt lgkmcnt(7)
    v_mfma_f32_16x16x32_bf16 v[96:99], v[64:67], v[32:35], 0
    s_waitcnt lgkmcnt(6)
    v_mfma_f32_16x16x32_bf16 v[96:99], v[68:71], v[36:39], v[96:99]
    s_waitcnt lgkmcnt(5)
    v_mfma_f32_16x16x32_bf16 v[96:99], v[72:75], v[40:43], v[96:99]
    s_waitcnt lgkmcnt(4)
    v_mfma_f32_16x16x32_bf16 v[96:99], v[76:79], v[44:47], v[96:99]
    s_waitcnt lgkmcnt(3)
    v_mfma_f32_16x16x32_bf16 v[96:99], v[80:83], v[48:51], v[96:99]
    s_waitcnt lgkmcnt(2)
    v_mfma_f32_16x16x32_bf16 v[96:99], v[84:87], v[52:55], v[96:99]
    s_waitcnt lgkmcnt(1)
    v_mfma_f32_16x16x32_bf16 v[96:99], v[88:91], v[56:59], v[96:99]
    s_waitcnt lgkmcnt(0)
    v_mfma_f32_16x16x32_bf16 v[96:99], v[92:95], v[60:63], v[96:99]
L_kskip1:
    s_waitcnt vmcnt(4)
    s_barrier
    s_add_u32 m0, s43, 0
    s_xor_b32 s44, s63, 131072
    buffer_load_dwordx4 v2, s[16:19], s44 offen offset:0 nt lds
    buffer_load_dwordx4 v3, s[16:19], s44 offen offset:1024 nt lds
    buffer_load_dwordx4 v4, s[16:19], s44 offen offset:2048 nt lds
    buffer_load_dwordx4 v5, s[16:19], s44 offen offset:3072 nt lds
    buffer_load_dword v196, v197, s[32:35], s59 offen offset:4 sc1
    s_cmp_lg_u32 s48, 0
    s_cbranch_scc1 L_kskip2
    ds_read_b128 v[64:67], v10 offset:32768
    ds_read_b128 v[68:71], v11 offset:32768
    ds_read_b128 v[72:75], v12 offset:32768
    ds_read_b128 v[76:79], v13 offset:32768
    ds_read_b128 v[80:83], v10 offset:33024
    ds_read_b128 v[84:87], v11 offset:33024
    ds_read_b128 v[88:91], v12 offset:33024
    ds_read_b128 v[92:95], v13 offset:33024
    v_max3_f32 v200, v96, v97, v98
    v_max_f32 v200, v200, v99
    s_waitcnt lgkmcnt(7)
    v_mfma_f32_16x16x32_bf16 v[100:103], v[64:67], v[32:35], 0
    s_waitcnt lgkmcnt(6)
    v_mfma_f32_16x16x32_bf16 v[100:103], v[68:71], v[36:39], v[100:103]
    s_waitcnt lgkmcnt(5)
    v_mfma_f32_16x16x32_bf16 v[100:103], v[72:75], v[40:43], v[100:103]
    s_waitcnt lgkmcnt(4)
    v_mfma_f32_16x16x32_bf16 v[100:103], v[76:79], v[44:47], v[100:103]
    s_waitcnt lgkmcnt(3)
    v_mfma_f32_16x16x32_bf16 v[100:103], v[80:83], v[48:51], v[100:103]
    s_waitcnt lgkmcnt(2)
    v_mfma_f32_16x16x32_bf16 v[100:103], v[84:87], v[52:55], v[100:103]
    s_waitcnt lgkmcnt(1)
    v_mfma_f32_16x16x32_bf16 v[100:103], v[88:91], v[56:59], v[100:103]
    s_waitcnt lgkmcnt(0)
    v_mfma_f32_16x16x32_bf16 v[100:103], v[92:95], v[60:63], v[100:103]
L_kskip2:
    s_waitcnt vmcnt(5)
    s_barrier
    s_add_u32 m0, s43, 65536
    s_xor_b32 s44, s63, 163840
    buffer_load_dwordx4 v2, s[16:19], s44 offen offset:0 nt lds
    buffer_load_dwordx4 v3, s[16:19], s44 offen offset:1024 nt lds
    buffer_load_dwordx4 v4, s[16:19], s44 offen offset:2048 nt lds
    buffer_load_dwordx4 v5, s[16:19], s44 offen offset:3072 nt lds
    s_cmp_lg_u32 s48, 1
    s_cbranch_scc1 L_kskip3
    ds_read_b128 v[64:67], v10 offset:32768
    ds_read_b128 v[68:71], v11 offset:32768
    ds_read_b128 v[72:75], v12 offset:32768
    ds_read_b128 v[76:79], v13 offset:32768
    ds_read_b128 v[80:83], v10 offset:33024
    ds_read_b128 v[84:87], v11 offset:33024
    ds_read_b128 v[88:91], v12 offset:33024
    ds_read_b128 v[92:95], v13 offset:33024
    v_max3_f32 v200, v96, v97, v98
    v_max_f32 v200, v200, v99
    s_waitcnt lgkmcnt(7)
    v_mfma_f32_16x16x32_bf16 v[100:103], v[64:67], v[32:35], 0
    s_waitcnt lgkmcnt(6)
    v_mfma_f32_16x16x32_bf16 v[100:103], v[68:71], v[36:39], v[100:103]
    s_waitcnt lgkmcnt(5)
    v_mfma_f32_16x16x32_bf16 v[100:103], v[72:75], v[40:43], v[100:103]
    s_waitcnt lgkmcnt(4)
    v_mfma_f32_16x16x32_bf16 v[100:103], v[76:79], v[44:47], v[100:103]
    s_waitcnt lgkmcnt(3)
    v_mfma_f32_16x16x32_bf16 v[100:103], v[80:83], v[48:51], v[100:103]
    s_waitcnt lgkmcnt(2)
    v_mfma_f32_16x16x32_bf16 v[100:103], v[84:87], v[52:55], v[100:103]
    s_waitcnt lgkmcnt(1)
    v_mfma_f32_16x16x32_bf16 v[100:103], v[88:91], v[56:59], v[100:103]
    s_waitcnt lgkmcnt(0)
    v_mfma_f32_16x16x32_bf16 v[100:103], v[92:95], v[60:63], v[100:103]
L_kskip3:
    s_waitcnt vmcnt(5)
    s_barrier
    s_add_u32 m0, s43, 32768
    s_xor_b32 s44, s63, 196608
    buffer_load_dwordx4 v2, s[16:19], s44 offen offset:0 nt lds
    buffer_load_dwordx4 v3, s[16:19], s44 offen offset:1024 nt lds
    buffer_load_dwordx4 v4, s[16:19], s44 offen offset:2048 nt lds
    buffer_load_dwordx4 v5, s[16:19], s44 offen offset:3072 nt lds
    s_cmp_lg_u32 s48, 0
    s_cbranch_scc1 L_kskip4
    ds_read_b128 v[64:67], v10 offset:0
    ds_read_b128 v[68:71], v11 offset:0
    ds_read_b128 v[72:75], v12 offset:0
    ds_read_b128 v[76:79], v13 offset:0
    ds_read_b128 v[80:83], v10 offset:256
    ds_read_b128 v[84:87], v11 offset:256
    ds_read_b128 v[88:91], v12 offset:256
    ds_read_b128 v[92:95], v13 offset:256
    v_max3_f32 v200, v200, v100, v101
    v_max3_f32 v200, v200, v102, v103
    s_waitcnt lgkmcnt(7)
    v_mfma_f32_16x16x32_bf16 v[104:107], v[64:67], v[32:35], 0
    s_waitcnt lgkmcnt(6)
    v_mfma_f32_16x16x32_bf16 v[104:107], v[68:71], v[36:39], v[104:107]
    s_waitcnt lgkmcnt(5)
    v_mfma_f32_16x16x32_bf16 v[104:107], v[72:75], v[40:43], v[104:107]
    s_waitcnt lgkmcnt(4)
    v_mfma_f32_16x16x32_bf16 v[104:107], v[76:79], v[44:47], v[104:107]
    s_waitcnt lgkmcnt(3)
    v_mfma_f32_16x16x32_bf16 v[104:107], v[80:83], v[48:51], v[104:107]
    s_waitcnt lgkmcnt(2)
    v_mfma_f32_16x16x32_bf16 v[104:107], v[84:87], v[52:55], v[104:107]
    s_waitcnt lgkmcnt(1)
    v_mfma_f32_16x16x32_bf16 v[104:107], v[88:91], v[56:59], v[104:107]
    s_waitcnt lgkmcnt(0)
    v_mfma_f32_16x16x32_bf16 v[104:107], v[92:95], v[60:63], v[104:107]
L_kskip4:
    s_waitcnt vmcnt(4)
    s_barrier
    s_add_u32 m0, s43, 98304
    s_xor_b32 s44, s63, 229376
    buffer_load_dwordx4 v2, s[16:19], s44 offen offset:0 nt lds
    buffer_load_dwordx4 v3, s[16:19], s44 offen offset:1024 nt lds
    buffer_load_dwordx4 v4, s[16:19], s44 offen offset:2048 nt lds
    buffer_load_dwordx4 v5, s[16:19], s44 offen offset:3072 nt lds
    s_cmp_lg_u32 s48, 1
    s_cbranch_scc1 L_kskip5
    ds_read_b128 v[64:67], v10 offset:0
    ds_read_b128 v[68:71], v11 offset:0
    ds_read_b128 v[72:75], v12 offset:0
    ds_read_b128 v[76:79], v13 offset:0
    ds_read_b128 v[80:83], v10 offset:256
    ds_read_b128 v[84:87], v11 offset:256
    ds_read_b128 v[88:91], v12 offset:256
    ds_read_b128 v[92:95], v13 offset:256
    v_max3_f32 v200, v200, v100, v101
    v_max3_f32 v200, v200, v102, v103
    s_waitcnt lgkmcnt(7)
    v_mfma_f32_16x16x32_bf16 v[104:107], v[64:67], v[32:35], 0
    s_waitcnt lgkmcnt(6)
    v_mfma_f32_16x16x32_bf16 v[104:107], v[68:71], v[36:39], v[104:107]
    s_waitcnt lgkmcnt(5)
    v_mfma_f32_16x16x32_bf16 v[104:107], v[72:75], v[40:43], v[104:107]
    s_waitcnt lgkmcnt(4)
    v_mfma_f32_16x16x32_bf16 v[104:107], v[76:79], v[44:47], v[104:107]
    s_waitcnt lgkmcnt(3)
    v_mfma_f32_16x16x32_bf16 v[104:107], v[80:83], v[48:51], v[104:107]
    s_waitcnt lgkmcnt(2)
    v_mfma_f32_16x16x32_bf16 v[104:107], v[84:87], v[52:55], v[104:107]
    s_waitcnt lgkmcnt(1)
    v_mfma_f32_16x16x32_bf16 v[104:107], v[88:91], v[56:59], v[104:107]
    s_waitcnt lgkmcnt(0)
    v_mfma_f32_16x16x32_bf16 v[104:107], v[92:95], v[60:63], v[104:107]
L_kskip5:
    s_waitcnt vmcnt(4)
    s_barrier
    s_add_u32 m0, s43, 0
    s_xor_b32 s44, s63, 262144
    buffer_load_dwordx4 v2, s[16:19], s44 offen offset:0 nt lds
    buffer_load_dwordx4 v3, s[16:19], s44 offen offset:1024 nt lds
    buffer_load_dwordx4 v4, s[16:19], s44 offen offset:2048 nt lds
    buffer_load_dwordx4 v5, s[16:19], s44 offen offset:3072 nt lds
    v_readfirstlane_b32 s45, v196
    s_getreg_b32 s46, hwreg(HW_REG_XCC_ID, 0, 4)
    s_nop 2
    s_mul_i32 s44, s45, 0x9e3779b1
    s_add_u32 s44, s44, 0x7f4a7c15
    s_lshr_b32 s68, s44, 15
    s_xor_b32 s44, s44, s68
    s_or_b32 s44, s44, 0x11111111
    s_xor_b32 s45, s45, s44
    s_bfe_u32 s68, s45, 0x40000
    s_bfe_u32 s69, s45, 0x40004
    s_bfe_u32 s70, s45, 0x40008
    s_bfe_u32 s71, s45, 0x4000c
    v_mov_b32 v196, s45
    v_mov_b32 v193, s45
    s_add_u32 s46, s46, s45
    s_add_u32 s46, s46, 1
    v_mov_b32 v198, s46
    s_cmp_eq_u32 s61, 0
    s_cbranch_scc1 L_nomsg
    s_mov_b64 exec, 1
    buffer_store_dword v198, v197, s[32:35], s59 offen sc1
    s_mov_b64 exec, -1
L_nomsg:
    s_cmp_lg_u32 s48, 0
    s_cbranch_scc1 L_kskip6
    ds_read_b128 v[64:67], v10 offset:32768
    ds_read_b128 v[68:71], v11 offset:32768
    ds_read_b128 v[72:75], v12 offset:32768
    ds_read_b128 v[76:79], v13 offset:32768
    ds_read_b128 v[80:83], v10 offset:33024
    ds_read_b128 v[84:87], v11 offset:33024
    ds_read_b128 v[88:91], v12 offset:33024
    ds_read_b128 v[92:95], v13 offset:33024
    v_max3_f32 v200, v200, v104, v105
    v_max3_f32 v200, v200, v106, v107
    s_waitcnt lgkmcnt(7)
    v_mfma_f32_16x16x32_bf16 v[108:111], v[64:67], v[32:35], 0
    s_waitcnt lgkmcnt(6)
    v_mfma_f32_16x16x32_bf16 v[108:111], v[68:71], v[36:39], v[108:111]
    s_waitcnt lgkmcnt(5)
    v_mfma_f32_16x16x32_bf16 v[108:111], v[72:75], v[40:43], v[108:111]
    s_waitcnt lgkmcnt(4)
    v_mfma_f32_16x16x32_bf16 v[108:111], v[76:79], v[44:47], v[108:111]
    s_waitcnt lgkmcnt(3)
    v_mfma_f32_16x16x32_bf16 v[108:111], v[80:83], v[48:51], v[108:111]
    s_waitcnt lgkmcnt(2)
    v_mfma_f32_16x16x32_bf16 v[108:111], v[84:87], v[52:55], v[108:111]
    s_waitcnt lgkmcnt(1)
    v_mfma_f32_16x16x32_bf16 v[108:111], v[88:91], v[56:59], v[108:111]
    s_waitcnt lgkmcnt(0)
    v_mfma_f32_16x16x32_bf16 v[108:111], v[92:95], v[60:63], v[108:111]
L_kskip6:
    s_waitcnt vmcnt(4)
    s_barrier
    s_add_u32 m0, s43, 65536
    s_xor_b32 s44, s63, 294912
    buffer_load_dwordx4 v2, s[16:19], s44 offen offset:0 nt lds
    buffer_load_dwordx4 v3, s[16:19], s44 offen offset:1024 nt lds
    buffer_load_dwordx4 v4, s[16:19], s44 offen offset:2048 nt lds
    buffer_load_dwordx4 v5, s[16:19], s44 offen offset:3072 nt lds
    s_cmp_lg_u32 s48, 1
    s_cbranch_scc1 L_kskip7
    ds_read_b128 v[64:67], v10 offset:32768
    ds_read_b128 v[68:71], v11 offset:32768
    ds_read_b128 v[72:75], v12 offset:32768
    ds_read_b128 v[76:79], v13 offset:32768
    ds_read_b128 v[80:83], v10 offset:33024
    ds_read_b128 v[84:87], v11 offset:33024
    ds_read_b128 v[88:91], v12 offset:33024
    ds_read_b128 v[92:95], v13 offset:33024
    v_max3_f32 v200, v200, v104, v105
    v_max3_f32 v200, v200, v106, v107
    s_waitcnt lgkmcnt(7)
    v_mfma_f32_16x16x32_bf16 v[108:111], v[64:67], v[32:35], 0
    s_waitcnt lgkmcnt(6)
    v_mfma_f32_16x16x32_bf16 v[108:111], v[68:71], v[36:39], v[108:111]
    s_waitcnt lgkmcnt(5)
    v_mfma_f32_16x16x32_bf16 v[108:111], v[72:75], v[40:43], v[108:111]
    s_waitcnt lgkmcnt(4)
    v_mfma_f32_16x16x32_bf16 v[108:111], v[76:79], v[44:47], v[108:111]
    s_waitcnt lgkmcnt(3)
    v_mfma_f32_16x16x32_bf16 v[108:111], v[80:83], v[48:51], v[108:111]
    s_waitcnt lgkmcnt(2)
    v_mfma_f32_16x16x32_bf16 v[108:111], v[84:87], v[52:55], v[108:111]
    s_waitcnt lgkmcnt(1)
    v_mfma_f32_16x16x32_bf16 v[108:111], v[88:91], v[56:59], v[108:111]
    s_waitcnt lgkmcnt(0)
    v_mfma_f32_16x16x32_bf16 v[108:111], v[92:95], v[60:63], v[108:111]
L_kskip7:
    s_waitcnt vmcnt(4)
    s_barrier
    s_add_u32 m0, s43, 32768
    s_xor_b32 s44, s63, 327680
    buffer_load_dwordx4 v2, s[16:19], s44 offen offset:0 nt lds
    buffer_load_dwordx4 v3, s[16:19], s44 offen offset:1024 nt lds
    buffer_load_dwordx4 v4, s[16:19], s44 offen offset:2048 nt lds
    buffer_load_dwordx4 v5, s[16:19], s44 offen offset:3072 nt lds
    s_cmp_lg_u32 s48, 0
    s_cbranch_scc1 L_kskip8
    ds_read_b128 v[64:67], v10 offset:0
    ds_read_b128 v[68:71], v11 offset:0
    ds_read_b128 v[72:75], v12 offset:0
    ds_read_b128 v[76:79], v13 offset:0
    ds_read_b128 v[80:83], v10 offset:256
    ds_read_b128 v[84:87], v11 offset:256
    ds_read_b128 v[88:91], v12 offset:256
    ds_read_b128 v[92:95], v13 offset:256
    v_max3_f32 v200, v200, v108, v109
    v_max3_f32 v200, v200, v110, v111
    s_waitcnt lgkmcnt(7)
    v_mfma_f32_16x16x32_bf16 v[112:115], v[64:67], v[32:35], 0
    s_waitcnt lgkmcnt(6)
    v_mfma_f32_16x16x32_bf16 v[112:115], v[68:71], v[36:39], v[112:115]
    s_waitcnt lgkmcnt(5)
    v_mfma_f32_16x16x32_bf16 v[112:115], v[72:75], v[40:43], v[112:115]
    s_waitcnt lgkmcnt(4)
    v_mfma_f32_16x16x32_bf16 v[112:115], v[76:79], v[44:47], v[112:115]
    s_waitcnt lgkmcnt(3)
    v_mfma_f32_16x16x32_bf16 v[112:115], v[80:83], v[48:51], v[112:115]
    s_waitcnt lgkmcnt(2)
    v_mfma_f32_16x16x32_bf16 v[112:115], v[84:87], v[52:55], v[112:115]
    s_waitcnt lgkmcnt(1)
    v_mfma_f32_16x16x32_bf16 v[112:115], v[88:91], v[56:59], v[112:115]
    s_waitcnt lgkmcnt(0)
    v_mfma_f32_16x16x32_bf16 v[112:115], v[92:95], v[60:63], v[112:115]
L_kskip8:
    s_waitcnt vmcnt(4)
    s_barrier
    s_add_u32 m0, s43, 98304
    s_xor_b32 s44, s63, 360448
    buffer_load_dwordx4 v2, s[16:19], s44 offen offset:0 nt lds
    buffer_load_dwordx4 v3, s[16:19], s44 offen offset:1024 nt lds
    buffer_load_dwordx4 v4, s[16:19], s44 offen offset:2048 nt lds
    buffer_load_dwordx4 v5, s[16:19], s44 offen offset:3072 nt lds
    s_cmp_lg_u32 s48, 1
    s_cbranch_scc1 L_kskip9
    ds_read_b128 v[64:67], v10 offset:0
    ds_read_b128 v[68:71], v11 offset:0
    ds_read_b128 v[72:75], v12 offset:0
    ds_read_b128 v[76:79], v13 offset:0
    ds_read_b128 v[80:83], v10 offset:256
    ds_read_b128 v[84:87], v11 offset:256
    ds_read_b128 v[88:91], v12 offset:256
    ds_read_b128 v[92:95], v13 offset:256
    v_max3_f32 v200, v200, v108, v109
    v_max3_f32 v200, v200, v110, v111
    s_waitcnt lgkmcnt(7)
    v_mfma_f32_16x16x32_bf16 v[112:115], v[64:67], v[32:35], 0
    s_waitcnt lgkmcnt(6)
    v_mfma_f32_16x16x32_bf16 v[112:115], v[68:71], v[36:39], v[112:115]
    s_waitcnt lgkmcnt(5)
    v_mfma_f32_16x16x32_bf16 v[112:115], v[72:75], v[40:43], v[112:115]
    s_waitcnt lgkmcnt(4)
    v_mfma_f32_16x16x32_bf16 v[112:115], v[76:79], v[44:47], v[112:115]
    s_waitcnt lgkmcnt(3)
    v_mfma_f32_16x16x32_bf16 v[112:115], v[80:83], v[48:51], v[112:115]
    s_waitcnt lgkmcnt(2)
    v_mfma_f32_16x16x32_bf16 v[112:115], v[84:87], v[52:55], v[112:115]
    s_waitcnt lgkmcnt(1)
    v_mfma_f32_16x16x32_bf16 v[112:115], v[88:91], v[56:59], v[112:115]
    s_waitcnt lgkmcnt(0)
    v_mfma_f32_16x16x32_bf16 v[112:115], v[92:95], v[60:63], v[112:115]
L_kskip9:
    s_waitcnt vmcnt(4)
    s_barrier
    s_add_u32 m0, s43, 0
    s_xor_b32 s44, s63, 393216
    buffer_load_dwordx4 v2, s[16:19], s44 offen offset:0 nt lds
    buffer_load_dwordx4 v3, s[16:19], s44 offen offset:1024 nt lds
    buffer_load_dwordx4 v4, s[16:19], s44 offen offset:2048 nt lds
    buffer_load_dwordx4 v5, s[16:19], s44 offen offset:3072 nt lds
    s_cmp_lg_u32 s48, 0
    s_cbranch_scc1 L_kskip10
    ds_read_b128 v[64:67], v10 offset:32768
    ds_read_b128 v[68:71], v11 offset:32768
    ds_read_b128 v[72:75], v12 offset:32768
    ds_read_b128 v[76:79], v13 offset:32768
    ds_read_b128 v[80:83], v10 offset:33024
    ds_read_b128 v[84:87], v11 offset:33024
    ds_read_b128 v[88:91], v12 offset:33024
    ds_read_b128 v[92:95], v13 offset:33024
    v_max3_f32 v200, v200, v112, v113
    v_max3_f32 v200, v200, v114, v115
    s_waitcnt lgkmcnt(7)
    v_mfma_f32_16x16x32_bf16 v[116:119], v[64:67], v[32:35], 0
    s_waitcnt lgkmcnt(6)
    v_mfma_f32_16x16x32_bf16 v[116:119], v[68:71], v[36:39], v[116:119]
    s_waitcnt lgkmcnt(5)
    v_mfma_f32_16x16x32_bf16 v[116:119], v[72:75], v[40:43], v[116:119]
    s_waitcnt lgkmcnt(4)
    v_mfma_f32_16x16x32_bf16 v[116:119], v[76:79], v[44:47], v[116:119]
    s_waitcnt lgkmcnt(3)
    v_mfma_f32_16x16x32_bf16 v[116:119], v[80:83], v[48:51], v[116:119]
    s_waitcnt lgkmcnt(2)
    v_mfma_f32_16x16x32_bf16 v[116:119], v[84:87], v[52:55], v[116:119]
    s_waitcnt lgkmcnt(1)
    v_mfma_f32_16x16x32_bf16 v[116:119], v[88:91], v[56:59], v[116:119]
    s_waitcnt lgkmcnt(0)
    v_mfma_f32_16x16x32_bf16 v[116:119], v[92:95], v[60:63], v[116:119]
L_kskip10:
    s_waitcnt vmcnt(4)
    s_barrier
    s_add_u32 m0, s43, 65536
    s_xor_b32 s44, s63, 425984
    buffer_load_dwordx4 v2, s[16:19], s44 offen offset:0 nt lds
    buffer_load_dwordx4 v3, s[16:19], s44 offen offset:1024 nt lds
    buffer_load_dwordx4 v4, s[16:19], s44 offen offset:2048 nt lds
    buffer_load_dwordx4 v5, s[16:19], s44 offen offset:3072 nt lds
    s_cmp_lg_u32 s48, 1
    s_cbranch_scc1 L_kskip11
    ds_read_b128 v[64:67], v10 offset:32768
    ds_read_b128 v[68:71], v11 offset:32768
    ds_read_b128 v[72:75], v12 offset:32768
    ds_read_b128 v[76:79], v13 offset:32768
    ds_read_b128 v[80:83], v10 offset:33024
    ds_read_b128 v[84:87], v11 offset:33024
    ds_read_b128 v[88:91], v12 offset:33024
    ds_read_b128 v[92:95], v13 offset:33024
    v_max3_f32 v200, v200, v112, v113
    v_max3_f32 v200, v200, v114, v115
    s_waitcnt lgkmcnt(7)
    v_mfma_f32_16x16x32_bf16 v[116:119], v[64:67], v[32:35], 0
    s_waitcnt lgkmcnt(6)
    v_mfma_f32_16x16x32_bf16 v[116:119], v[68:71], v[36:39], v[116:119]
    s_waitcnt lgkmcnt(5)
    v_mfma_f32_16x16x32_bf16 v[116:119], v[72:75], v[40:43], v[116:119]
    s_waitcnt lgkmcnt(4)
    v_mfma_f32_16x16x32_bf16 v[116:119], v[76:79], v[44:47], v[116:119]
    s_waitcnt lgkmcnt(3)
    v_mfma_f32_16x16x32_bf16 v[116:119], v[80:83], v[48:51], v[116:119]
    s_waitcnt lgkmcnt(2)
    v_mfma_f32_16x16x32_bf16 v[116:119], v[84:87], v[52:55], v[116:119]
    s_waitcnt lgkmcnt(1)
    v_mfma_f32_16x16x32_bf16 v[116:119], v[88:91], v[56:59], v[116:119]
    s_waitcnt lgkmcnt(0)
    v_mfma_f32_16x16x32_bf16 v[116:119], v[92:95], v[60:63], v[116:119]
L_kskip11:
    s_waitcnt vmcnt(4)
    s_barrier
    s_add_u32 m0, s43, 32768
    s_xor_b32 s44, s63, 458752
    buffer_load_dwordx4 v2, s[16:19], s44 offen offset:0 nt lds
    buffer_load_dwordx4 v3, s[16:19], s44 offen offset:1024 nt lds
    buffer_load_dwordx4 v4, s[16:19], s44 offen offset:2048 nt lds
    buffer_load_dwordx4 v5, s[16:19], s44 offen offset:3072 nt lds
    s_cmp_lg_u32 s48, 0
    s_cbranch_scc1 L_kskip12
    ds_read_b128 v[64:67], v10 offset:0
    ds_read_b128 v[68:71], v11 offset:0
    ds_read_b128 v[72:75], v12 offset:0
    ds_read_b128 v[76:79], v13 offset:0
    ds_read_b128 v[80:83], v10 offset:256
    ds_read_b128 v[84:87], v11 offset:256
    ds_read_b128 v[88:91], v12 offset:256
    ds_read_b128 v[92:95], v13 offset:256
    v_max3_f32 v200, v200, v116, v117
    v_max3_f32 v200, v200, v118, v119
    s_waitcnt lgkmcnt(7)
    v_mfma_f32_16x16x32_bf16 v[120:123], v[64:67], v[32:35], 0
    s_waitcnt lgkmcnt(6)
    v_mfma_f32_16x16x32_bf16 v[120:123], v[68:71], v[36:39], v[120:123]
    s_waitcnt lgkmcnt(5)
    v_mfma_f32_16x16x32_bf16 v[120:123], v[72:75], v[40:43], v[120:123]
    s_waitcnt lgkmcnt(4)
    v_mfma_f32_16x16x32_bf16 v[120:123], v[76:79], v[44:47], v[120:123]
    s_waitcnt lgkmcnt(3)
    v_mfma_f32_16x16x32_bf16 v[120:123], v[80:83], v[48:51], v[120:123]
    s_waitcnt lgkmcnt(2)
    v_mfma_f32_16x16x32_bf16 v[120:123], v[84:87], v[52:55], v[120:123]
    s_waitcnt lgkmcnt(1)
    v_mfma_f32_16x16x32_bf16 v[120:123], v[88:91], v[56:59], v[120:123]
    s_waitcnt lgkmcnt(0)
    v_mfma_f32_16x16x32_bf16 v[120:123], v[92:95], v[60:63], v[120:123]
L_kskip12:
    s_waitcnt vmcnt(4)
    s_barrier
    s_add_u32 m0, s43, 98304
    s_xor_b32 s44, s63, 491520
    buffer_load_dwordx4 v2, s[16:19], s44 offen offset:0 nt lds
    buffer_load_dwordx4 v3, s[16:19], s44 offen offset:1024 nt lds
    buffer_load_dwordx4 v4, s[16:19], s44 offen offset:2048 nt lds
    buffer_load_dwordx4 v5, s[16:19], s44 offen offset:3072 nt lds
    s_cmp_lg_u32 s48, 1
    s_cbranch_scc1 L_kskip13
    ds_read_b128 v[64:67], v10 offset:0
    ds_read_b128 v[68:71], v11 offset:0
    ds_read_b128 v[72:75], v12 offset:0
    ds_read_b128 v[76:79], v13 offset:0
    ds_read_b128 v[80:83], v10 offset:256
    ds_read_b128 v[84:87], v11 offset:256
    ds_read_b128 v[88:91], v12 offset:256
    ds_read_b128 v[92:95], v13 offset:256
    v_max3_f32 v200, v200, v116, v117
    v_max3_f32 v200, v200, v118, v119
    s_waitcnt lgkmcnt(7)
    v_mfma_f32_16x16x32_bf16 v[120:123], v[64:67], v[32:35], 0
    s_waitcnt lgkmcnt(6)
    v_mfma_f32_16x16x32_bf16 v[120:123], v[68:71], v[36:39], v[120:123]
    s_waitcnt lgkmcnt(5)
    v_mfma_f32_16x16x32_bf16 v[120:123], v[72:75], v[40:43], v[120:123]
    s_waitcnt lgkmcnt(4)
    v_mfma_f32_16x16x32_bf16 v[120:123], v[76:79], v[44:47], v[120:123]
    s_waitcnt lgkmcnt(3)
    v_mfma_f32_16x16x32_bf16 v[120:123], v[80:83], v[48:51], v[120:123]
    s_waitcnt lgkmcnt(2)
    v_mfma_f32_16x16x32_bf16 v[120:123], v[84:87], v[52:55], v[120:123]
    s_waitcnt lgkmcnt(1)
    v_mfma_f32_16x16x32_bf16 v[120:123], v[88:91], v[56:59], v[120:123]
    s_waitcnt lgkmcnt(0)
    v_mfma_f32_16x16x32_bf16 v[120:123], v[92:95], v[60:63], v[120:123]
L_kskip13:
    s_waitcnt vmcnt(4)
    s_barrier
    s_add_u32 m0, s43, 0
    s_nop 0
    buffer_load_dwordx4 v6, s[20:23], s63 offen offset:0 nt lds
    buffer_load_dwordx4 v7, s[20:23], s63 offen offset:1024 nt lds
    buffer_load_dwordx4 v8, s[20:23], s63 offen offset:2048 nt lds
    buffer_load_dwordx4 v9, s[20:23], s63 offen offset:3072 nt lds
    s_cmp_lg_u32 s48, 0
    s_cbranch_scc1 L_kskip14
    ds_read_b128 v[64:67], v10 offset:32768
    ds_read_b128 v[68:71], v11 offset:32768
    ds_read_b128 v[72:75], v12 offset:32768
    ds_read_b128 v[76:79], v13 offset:32768
    ds_read_b128 v[80:83], v10 offset:33024
    ds_read_b128 v[84:87], v11 offset:33024
    ds_read_b128 v[88:91], v12 offset:33024
    ds_read_b128 v[92:95], v13 offset:33024
    v_max3_f32 v200, v200, v120, v121
    v_max3_f32 v200, v200, v122, v123
    s_waitcnt lgkmcnt(7)
    v_mfma_f32_16x16x32_bf16 v[124:127], v[64:67], v[32:35], 0
    s_waitcnt lgkmcnt(6)
    v_mfma_f32_16x16x32_bf16 v[124:127], v[68:71], v[36:39], v[124:127]
    s_waitcnt lgkmcnt(5)
    v_mfma_f32_16x16x32_bf16 v[124:127], v[72:75], v[40:43], v[124:127]
    s_waitcnt lgkmcnt(4)
    v_mfma_f32_16x16x32_bf16 v[124:127], v[76:79], v[44:47], v[124:127]
    s_waitcnt lgkmcnt(3)
    v_mfma_f32_16x16x32_bf16 v[124:127], v[80:83], v[48:51], v[124:127]
    s_waitcnt lgkmcnt(2)
    v_mfma_f32_16x16x32_bf16 v[124:127], v[84:87], v[52:55], v[124:127]
    s_waitcnt lgkmcnt(1)
    v_mfma_f32_16x16x32_bf16 v[124:127], v[88:91], v[56:59], v[124:127]
    s_waitcnt lgkmcnt(0)
    v_mfma_f32_16x16x32_bf16 v[124:127], v[92:95], v[60:63], v[124:127]
L_kskip14:
    s_waitcnt vmcnt(4)
    s_barrier
    s_add_u32 m0, s43, 65536
    s_xor_b32 s44, s63, 32768
    buffer_load_dwordx4 v6, s[20:23], s44 offen offset:0 nt lds
    buffer_load_dwordx4 v7, s[20:23], s44 offen offset:1024 nt lds
    buffer_load_dwordx4 v8, s[20:23], s44 offen offset:2048 nt lds
    buffer_load_dwordx4 v9, s[20:23], s44 offen offset:3072 nt lds
    s_cmp_lg_u32 s48, 1
    s_cbranch_scc1 L_kskip15
    ds_read_b128 v[64:67], v10 offset:32768
    ds_read_b128 v[68:71], v11 offset:32768
    ds_read_b128 v[72:75], v12 offset:32768
    ds_read_b128 v[76:79], v13 offset:32768
    ds_read_b128 v[80:83], v10 offset:33024
    ds_read_b128 v[84:87], v11 offset:33024
    ds_read_b128 v[88:91], v12 offset:33024
    ds_read_b128 v[92:95], v13 offset:33024
    v_max3_f32 v200, v200, v120, v121
    v_max3_f32 v200, v200, v122, v123
    s_waitcnt lgkmcnt(7)
    v_mfma_f32_16x16x32_bf16 v[124:127], v[64:67], v[32:35], 0
    s_waitcnt lgkmcnt(6)
    v_mfma_f32_16x16x32_bf16 v[124:127], v[68:71], v[36:39], v[124:127]
    s_waitcnt lgkmcnt(5)
    v_mfma_f32_16x16x32_bf16 v[124:127], v[72:75], v[40:43], v[124:127]
    s_waitcnt lgkmcnt(4)
    v_mfma_f32_16x16x32_bf16 v[124:127], v[76:79], v[44:47], v[124:127]
    s_waitcnt lgkmcnt(3)
    v_mfma_f32_16x16x32_bf16 v[124:127], v[80:83], v[48:51], v[124:127]
    s_waitcnt lgkmcnt(2)
    v_mfma_f32_16x16x32_bf16 v[124:127], v[84:87], v[52:55], v[124:127]
    s_waitcnt lgkmcnt(1)
    v_mfma_f32_16x16x32_bf16 v[124:127], v[88:91], v[56:59], v[124:127]
    s_waitcnt lgkmcnt(0)
    v_mfma_f32_16x16x32_bf16 v[124:127], v[92:95], v[60:63], v[124:127]
L_kskip15:
    s_nop 7
    s_nop 1
    v_max3_f32 v200, v200, v124, v125
    v_max3_f32 v200, v200, v126, v127
    v_mov_b32 v22, v200
    s_nop 1
    v_permlane32_swap_b32 v200, v22
    v_max_f32 v200, v200, v22
    v_mov_b32 v22, v200
    s_nop 1
    v_permlane16_swap_b32 v200, v22
    v_max_f32 v200, v200, v22
    ds_write_b32 v20, v200
    s_waitcnt lgkmcnt(0)
    s_barrier
    ds_read_b128 v[64:67], v21
    ds_read_b128 v[68:71], v21 offset:16
    s_add_u32 m0, s43, 32768
    s_xor_b32 s44, s63, 65536
    buffer_load_dwordx4 v6, s[20:23], s44 offen offset:0 nt lds
    buffer_load_dwordx4 v7, s[20:23], s44 offen offset:1024 nt lds
    buffer_load_dwordx4 v8, s[20:23], s44 offen offset:2048 nt lds
    buffer_load_dwordx4 v9, s[20:23], s44 offen offset:3072 nt lds
    s_waitcnt lgkmcnt(0)
    v_max3_f32 v200, v64, v65, v66
    v_max3_f32 v22, v67, v68, v69
    v_max3_f32 v200, v200, v70, v71
    v_max_f32 v200, v200, v22
    v_mul_f32 v200, s47, v200
    v_fma_f32 v96, v96, s47, -v200
    v_fma_f32 v97, v97, s47, -v200
    v_fma_f32 v98, v98, s47, -v200
    v_fma_f32 v99, v99, s47, -v200
    v_fma_f32 v100, v100, s47, -v200
    v_fma_f32 v101, v101, s47, -v200
    v_fma_f32 v102, v102, s47, -v200
    v_fma_f32 v103, v103, s47, -v200
    v_fma_f32 v104, v104, s47, -v200
    v_fma_f32 v105, v105, s47, -v200
    v_fma_f32 v106, v106, s47, -v200
    v_fma_f32 v107, v107, s47, -v200
    v_fma_f32 v108, v108, s47, -v200
    v_fma_f32 v109, v109, s47, -v200
    v_fma_f32 v110, v110, s47, -v200
    v_fma_f32 v111, v111, s47, -v200
    v_fma_f32 v112, v112, s47, -v200
    v_fma_f32 v113, v113, s47, -v200
    v_fma_f32 v114, v114, s47, -v200
    v_fma_f32 v115, v115, s47, -v200
    v_fma_f32 v116, v116, s47, -v200
    v_fma_f32 v117, v117, s47, -v200
    v_fma_f32 v118, v118, s47, -v200
    v_fma_f32 v119, v119, s47, -v200
    v_fma_f32 v120, v120, s47, -v200
    v_fma_f32 v121, v121, s47, -v200
    v_fma_f32 v122, v122, s47, -v200
    v_fma_f32 v123, v123, s47, -v200
    v_fma_f32 v124, v124, s47, -v200
    v_fma_f32 v125, v125, s47, -v200
    v_fma_f32 v126, v126, s47, -v200
    v_fma_f32 v127, v127, s47, -v200
    v_exp_f32 v96, v96
    v_exp_f32 v97, v97
    v_exp_f32 v98, v98
    v_exp_f32 v99, v99
    v_exp_f32 v100, v100
    v_exp_f32 v101, v101
    v_exp_f32 v102, v102
    v_exp_f32 v103, v103
    v_exp_f32 v104, v104
    v_exp_f32 v105, v105
    v_exp_f32 v106, v106
    v_exp_f32 v107, v107
    v_exp_f32 v108, v108
    v_exp_f32 v109, v109
    v_exp_f32 v110, v110
    v_exp_f32 v111, v111
    v_exp_f32 v112, v112
    v_exp_f32 v113, v113
    v_exp_f32 v114, v114
    v_exp_f32 v115, v115
    v_exp_f32 v116, v116
    v_exp_f32 v117, v117
    v_exp_f32 v118, v118
    v_exp_f32 v119, v119
    v_exp_f32 v120, v120
    v_exp_f32 v121, v121
    v_exp_f32 v122, v122
    v_exp_f32 v123, v123
    v_exp_f32 v124, v124
    v_exp_f32 v125, v125
    v_exp_f32 v126, v126
    v_exp_f32 v127, v127
    s_nop 0
    v_cvt_pk_bf16_f32 v128, v96, v97
    v_cvt_pk_bf16_f32 v129, v98, v99
    ds_write_b64 v19, v[128:129] offset:0
    v_cvt_pk_bf16_f32 v130, v100, v101
    v_cvt_pk_bf16_f32 v131, v102, v103
    ds_write_b64 v19, v[130:131] offset:4096
    v_cvt_pk_bf16_f32 v132, v104, v105
    v_cvt_pk_bf16_f32 v133, v106, v107
    ds_write_b64 v19, v[132:133] offset:8192
    v_cvt_pk_bf16_f32 v134, v108, v109
    v_cvt_pk_bf16_f32 v135, v110, v111
    ds_write_b64 v19, v[134:135] offset:12288
    v_cvt_pk_bf16_f32 v136, v112, v113
    v_cvt_pk_bf16_f32 v137, v114, v115
    ds_write_b64 v19, v[136:137] offset:16384
    v_cvt_pk_bf16_f32 v138, v116, v117
    v_cvt_pk_bf16_f32 v139, v118, v119
    ds_write_b64 v19, v[138:139] offset:20480
    v_cvt_pk_bf16_f32 v140, v120, v121
    v_cvt_pk_bf16_f32 v141, v122, v123
    ds_write_b64 v19, v[140:141] offset:24576
    v_cvt_pk_bf16_f32 v142, v124, v125
    v_cvt_pk_bf16_f32 v143, v126, v127
    v_add_f32 v201, v96, v97
    v_add_f32 v23, v98, v99
    v_add_f32 v201, v201, v100
    v_add_f32 v23, v23, v101
    v_add_f32 v201, v201, v102
    v_add_f32 v23, v23, v103
    v_add_f32 v201, v201, v104
    v_add_f32 v23, v23, v105
    v_add_f32 v201, v201, v106
    v_add_f32 v23, v23, v107
    v_add_f32 v201, v201, v108
    v_add_f32 v23, v23, v109
    v_add_f32 v201, v201, v110
    v_add_f32 v23, v23, v111
    v_add_f32 v201, v201, v112
    v_add_f32 v23, v23, v113
    v_add_f32 v201, v201, v114
    v_add_f32 v23, v23, v115
    v_add_f32 v201, v201, v116
    v_add_f32 v23, v23, v117
    v_add_f32 v201, v201, v118
    v_add_f32 v23, v23, v119
    v_add_f32 v201, v201, v120
    v_add_f32 v23, v23, v121
    v_add_f32 v201, v201, v122
    v_add_f32 v23, v23, v123
    v_add_f32 v201, v201, v124
    v_add_f32 v23, v23, v125
    v_add_f32 v201, v201, v126
    v_add_f32 v23, v23, v127
    v_add_f32 v201, v201, v23
    v_mov_b32 v22, v201
    s_nop 1
    v_permlane32_swap_b32 v201, v22
    v_add_f32 v201, v201, v22
    v_mov_b32 v22, v201
    s_nop 1
    v_permlane16_swap_b32 v201, v22
    v_add_f32 v201, v201, v22
    ds_write_b32 v20, v201 offset:512
    s_waitcnt vmcnt(8) lgkmcnt(0)
    s_barrier
    ds_read_b128 v[160:163], v18 offset:0
    ds_read_b128 v[164:167], v18 offset:1024
    ds_read_b64_tr_b16 v[144:145], v14 offset:0
    ds_read_b64_tr_b16 v[146:147], v14 offset:8192
    ds_read_b64_tr_b16 v[148:149], v15 offset:0
    ds_read_b64_tr_b16 v[150:151], v15 offset:8192
    ds_read_b64_tr_b16 v[152:153], v14 offset:16384
    ds_read_b64_tr_b16 v[154:155], v14 offset:24576
    ds_read_b64_tr_b16 v[156:157], v15 offset:16384
    ds_read_b64_tr_b16 v[158:159], v15 offset:24576
    ds_read_b128 v[168:171], v18 offset:2048
    ds_read_b128 v[172:175], v18 offset:3072
    s_waitcnt lgkmcnt(8)
    v_mfma_f32_16x16x32_bf16 v[176:179], v[144:147], v[160:163], v[176:179]
    s_waitcnt lgkmcnt(6)
    v_mfma_f32_16x16x32_bf16 v[180:183], v[148:151], v[160:163], v[180:183]
    s_waitcnt lgkmcnt(4)
    v_mfma_f32_16x16x32_bf16 v[176:179], v[152:155], v[164:167], v[176:179]
    s_waitcnt lgkmcnt(2)
    v_mfma_f32_16x16x32_bf16 v[180:183], v[156:159], v[164:167], v[180:183]
    s_waitcnt vmcnt(4) lgkmcnt(0)
    s_barrier
    s_add_u32 m0, s43, 98304
    s_xor_b32 s44, s63, 98304
    buffer_load_dwordx4 v6, s[20:23], s44 offen offset:0 nt lds
    buffer_load_dwordx4 v7, s[20:23], s44 offen offset:1024 nt lds
    buffer_load_dwordx4 v8, s[20:23], s44 offen offset:2048 nt lds
    buffer_load_dwordx4 v9, s[20:23], s44 offen offset:3072 nt lds
    ds_read_b64_tr_b16 v[144:145], v16 offset:0
    ds_read_b64_tr_b16 v[146:147], v16 offset:8192
    ds_read_b64_tr_b16 v[148:149], v17 offset:0
    ds_read_b64_tr_b16 v[150:151], v17 offset:8192
    ds_read_b64_tr_b16 v[152:153], v16 offset:16384
    ds_read_b64_tr_b16 v[154:155], v16 offset:24576
    ds_read_b64_tr_b16 v[156:157], v17 offset:16384
    ds_read_b64_tr_b16 v[158:159], v17 offset:24576
    ds_read_b128 v[160:163], v18 offset:4096
    ds_read_b128 v[164:167], v18 offset:5120
    ds_read_b128 v[64:67], v21 offset:512
    ds_read_b128 v[68:71], v21 offset:528
    s_waitcnt lgkmcnt(10)
    v_mfma_f32_16x16x32_bf16 v[176:179], v[144:147], v[168:171], v[176:179]
    s_waitcnt lgkmcnt(8)
    v_mfma_f32_16x16x32_bf16 v[180:183], v[148:151], v[168:171], v[180:183]
    s_waitcnt lgkmcnt(6)
    v_mfma_f32_16x16x32_bf16 v[176:179], v[152:155], v[172:175], v[176:179]
    s_waitcnt lgkmcnt(4)
    v_mfma_f32_16x16x32_bf16 v[180:183], v[156:159], v[172:175], v[180:183]
    s_waitcnt lgkmcnt(0)
    v_add_f32 v64, v64, v65
    v_add_f32 v66, v66, v67
    v_add_f32 v68, v68, v69
    v_add_f32 v70, v70, v71
    v_add_f32 v64, v64, v66
    v_add_f32 v68, v68, v70
    v_add_f32 v201, v64, v68
    v_log_f32 v22, v201
    v_rcp_f32 v201, v201
    s_nop 0
    v_add_f32 v200, v200, v22
    v_mov_b32 v192, v200
    s_waitcnt vmcnt(4) lgkmcnt(0)
    s_barrier
    s_add_u32 m0, s43, 0
    s_xor_b32 s44, s63, 131072
    buffer_load_dwordx4 v6, s[20:23], s44 offen offset:0 nt lds
    buffer_load_dwordx4 v7, s[20:23], s44 offen offset:1024 nt lds
    buffer_load_dwordx4 v8, s[20:23], s44 offen offset:2048 nt lds
    buffer_load_dwordx4 v9, s[20:23], s44 offen offset:3072 nt lds
    ds_read_b64_tr_b16 v[144:145], v14 offset:32768
    ds_read_b64_tr_b16 v[146:147], v14 offset:40960
    ds_read_b64_tr_b16 v[148:149], v15 offset:32768
    ds_read_b64_tr_b16 v[150:151], v15 offset:40960
    ds_read_b64_tr_b16 v[152:153], v14 offset:49152
    ds_read_b64_tr_b16 v[154:155], v14 offset:57344
    ds_read_b64_tr_b16 v[156:157], v15 offset:49152
    ds_read_b64_tr_b16 v[158:159], v15 offset:57344
    ds_read_b128 v[168:171], v18 offset:6144
    ds_read_b128 v[172:175], v18 offset:7168
    s_waitcnt lgkmcnt(8)
    v_mfma_f32_16x16x32_bf16 v[176:179], v[144:147], v[160:163], v[176:179]
    s_waitcnt lgkmcnt(6)
    v_mfma_f32_16x16x32_bf16 v[180:183], v[148:151], v[160:163], v[180:183]
    s_waitcnt lgkmcnt(4)
    v_mfma_f32_16x16x32_bf16 v[176:179], v[152:155], v[164:167], v[176:179]
    s_waitcnt lgkmcnt(2)
    v_mfma_f32_16x16x32_bf16 v[180:183], v[156:159], v[164:167], v[180:183]
    s_waitcnt vmcnt(4) lgkmcnt(0)
    s_barrier
    s_add_u32 m0, s43, 65536
    s_xor_b32 s44, s63, 163840
    buffer_load_dwordx4 v6, s[20:23], s44 offen offset:0 nt lds
    buffer_load_dwordx4 v7, s[20:23], s44 offen offset:1024 nt lds
    buffer_load_dwordx4 v8, s[20:23], s44 offen offset:2048 nt lds
    buffer_load_dwordx4 v9, s[20:23], s44 offen offset:3072 nt lds
    ds_read_b64_tr_b16 v[144:145], v16 offset:32768
    ds_read_b64_tr_b16 v[146:147], v16 offset:40960
    ds_read_b64_tr_b16 v[148:149], v17 offset:32768
    ds_read_b64_tr_b16 v[150:151], v17 offset:40960
    ds_read_b64_tr_b16 v[152:153], v16 offset:49152
    ds_read_b64_tr_b16 v[154:155], v16 offset:57344
    ds_read_b64_tr_b16 v[156:157], v17 offset:49152
    ds_read_b64_tr_b16 v[158:159], v17 offset:57344
    ds_read_b128 v[160:163], v18 offset:8192
    ds_read_b128 v[164:167], v18 offset:9216
    ds_write_b64 v19, v[142:143]
    s_waitcnt lgkmcnt(9)
    v_mfma_f32_16x16x32_bf16 v[176:179], v[144:147], v[168:171], v[176:179]
    s_waitcnt lgkmcnt(7)
    v_mfma_f32_16x16x32_bf16 v[180:183], v[148:151], v[168:171], v[180:183]
    s_waitcnt lgkmcnt(5)
    v_mfma_f32_16x16x32_bf16 v[176:179], v[152:155], v[172:175], v[176:179]
    s_waitcnt lgkmcnt(3)
    v_mfma_f32_16x16x32_bf16 v[180:183], v[156:159], v[172:175], v[180:183]
    s_waitcnt vmcnt(4) lgkmcnt(0)
    s_barrier
    s_add_u32 m0, s43, 32768
    s_xor_b32 s44, s63, 196608
    buffer_load_dwordx4 v6, s[20:23], s44 offen offset:0 nt lds
    buffer_load_dwordx4 v7, s[20:23], s44 offen offset:1024 nt lds
    buffer_load_dwordx4 v8, s[20:23], s44 offen offset:2048 nt lds
    buffer_load_dwordx4 v9, s[20:23], s44 offen offset:3072 nt lds
    ds_read_b64_tr_b16 v[144:145], v14 offset:0
    ds_read_b64_tr_b16 v[146:147], v14 offset:8192
    ds_read_b64_tr_b16 v[148:149], v15 offset:0
    ds_read_b64_tr_b16 v[150:151], v15 offset:8192
    ds_read_b64_tr_b16 v[152:153], v14 offset:16384
    ds_read_b64_tr_b16 v[154:155], v14 offset:24576
    ds_read_b64_tr_b16 v[156:157], v15 offset:16384
    ds_read_b64_tr_b16 v[158:159], v15 offset:24576
    ds_read_b128 v[168:171], v18 offset:10240
    ds_read_b128 v[172:175], v18 offset:11264
    s_waitcnt lgkmcnt(8)
    v_mfma_f32_16x16x32_bf16 v[176:179], v[144:147], v[160:163], v[176:179]
    s_waitcnt lgkmcnt(6)
    v_mfma_f32_16x16x32_bf16 v[180:183], v[148:151], v[160:163], v[180:183]
    s_waitcnt lgkmcnt(4)
    v_mfma_f32_16x16x32_bf16 v[176:179], v[152:155], v[164:167], v[176:179]
    s_waitcnt lgkmcnt(2)
    v_mfma_f32_16x16x32_bf16 v[180:183], v[156:159], v[164:167], v[180:183]
    s_waitcnt vmcnt(4) lgkmcnt(0)
    s_barrier
    s_add_u32 m0, s43, 98304
    s_xor_b32 s44, s63, 229376
    buffer_load_dwordx4 v6, s[20:23], s44 offen offset:0 nt lds
    buffer_load_dwordx4 v7, s[20:23], s44 offen offset:1024 nt lds
    buffer_load_dwordx4 v8, s[20:23], s44 offen offset:2048 nt lds
    buffer_load_dwordx4 v9, s[20:23], s44 offen offset:3072 nt lds
    ds_read_b64_tr_b16 v[144:145], v16 offset:0
    ds_read_b64_tr_b16 v[146:147], v16 offset:8192
    ds_read_b64_tr_b16 v[148:149], v17 offset:0
    ds_read_b64_tr_b16 v[150:151], v17 offset:8192
    ds_read_b64_tr_b16 v[152:153], v16 offset:16384
    ds_read_b64_tr_b16 v[154:155], v16 offset:24576
    ds_read_b64_tr_b16 v[156:157], v17 offset:16384
    ds_read_b64_tr_b16 v[158:159], v17 offset:24576
    ds_read_b128 v[160:163], v18 offset:12288
    ds_read_b128 v[164:167], v18 offset:13312
    s_waitcnt lgkmcnt(8)
    v_mfma_f32_16x16x32_bf16 v[176:179], v[144:147], v[168:171], v[176:179]
    s_waitcnt lgkmcnt(6)
    v_mfma_f32_16x16x32_bf16 v[180:183], v[148:151], v[168:171], v[180:183]
    s_waitcnt lgkmcnt(4)
    v_mfma_f32_16x16x32_bf16 v[176:179], v[152:155], v[172:175], v[176:179]
    s_waitcnt lgkmcnt(2)
    v_mfma_f32_16x16x32_bf16 v[180:183], v[156:159], v[172:175], v[180:183]
    s_waitcnt vmcnt(4) lgkmcnt(0)
    s_barrier
    s_add_u32 m0, s43, 0
    s_xor_b32 s44, s63, 262144
    buffer_load_dwordx4 v6, s[20:23], s44 offen offset:0 nt lds
    buffer_load_dwordx4 v7, s[20:23], s44 offen offset:1024 nt lds
    buffer_load_dwordx4 v8, s[20:23], s44 offen offset:2048 nt lds
    buffer_load_dwordx4 v9, s[20:23], s44 offen offset:3072 nt lds
    ds_read_b64_tr_b16 v[144:145], v14 offset:32768
    ds_read_b64_tr_b16 v[146:147], v14 offset:40960
    ds_read_b64_tr_b16 v[148:149], v15 offset:32768
    ds_read_b64_tr_b16 v[150:151], v15 offset:40960
    ds_read_b64_tr_b16 v[152:153], v14 offset:49152
    ds_read_b64_tr_b16 v[154:155], v14 offset:57344
    ds_read_b64_tr_b16 v[156:157], v15 offset:49152
    ds_read_b64_tr_b16 v[158:159], v15 offset:57344
    ds_read_b128 v[168:171], v18 offset:14336
    ds_read_b128 v[172:175], v18 offset:15360
    s_waitcnt lgkmcnt(8)
    v_mfma_f32_16x16x32_bf16 v[176:179], v[144:147], v[160:163], v[176:179]
    s_waitcnt lgkmcnt(6)
    v_mfma_f32_16x16x32_bf16 v[180:183], v[148:151], v[160:163], v[180:183]
    s_waitcnt lgkmcnt(4)
    v_mfma_f32_16x16x32_bf16 v[176:179], v[152:155], v[164:167], v[176:179]
    s_waitcnt lgkmcnt(2)
    v_mfma_f32_16x16x32_bf16 v[180:183], v[156:159], v[164:167], v[180:183]
    s_waitcnt vmcnt(4) lgkmcnt(0)
    s_barrier
    s_add_u32 m0, s43, 65536
    s_xor_b32 s44, s63, 294912
    buffer_load_dwordx4 v6, s[20:23], s44 offen offset:0 nt lds
    buffer_load_dwordx4 v7, s[20:23], s44 offen offset:1024 nt lds
    buffer_load_dwordx4 v8, s[20:23], s44 offen offset:2048 nt lds
    buffer_load_dwordx4 v9, s[20:23], s44 offen offset:3072 nt lds
    buffer_load_dword v199, v197, s[32:35], s59 offen sc1
    ds_read_b64_tr_b16 v[144:145], v16 offset:32768
    ds_read_b64_tr_b16 v[146:147], v16 offset:40960
    ds_read_b64_tr_b16 v[148:149], v17 offset:32768
    ds_read_b64_tr_b16 v[150:151], v17 offset:40960
    ds_read_b64_tr_b16 v[152:153], v16 offset:49152
    ds_read_b64_tr_b16 v[154:155], v16 offset:57344
    ds_read_b64_tr_b16 v[156:157], v17 offset:49152
    ds_read_b64_tr_b16 v[158:159], v17 offset:57344
    ds_read_b128 v[160:163], v18 offset:16384
    ds_read_b128 v[164:167], v18 offset:17408
    s_waitcnt lgkmcnt(8)
    v_mfma_f32_16x16x32_bf16 v[176:179], v[144:147], v[168:171], v[176:179]
    s_waitcnt lgkmcnt(6)
    v_mfma_f32_16x16x32_bf16 v[180:183], v[148:151], v[168:171], v[180:183]
    s_waitcnt lgkmcnt(4)
    v_mfma_f32_16x16x32_bf16 v[176:179], v[152:155], v[172:175], v[176:179]
    s_waitcnt lgkmcnt(2)
    v_mfma_f32_16x16x32_bf16 v[180:183], v[156:159], v[172:175], v[180:183]
    s_waitcnt vmcnt(5) lgkmcnt(0)
    s_barrier
    s_add_u32 m0, s43, 32768
    s_xor_b32 s44, s63, 327680
    buffer_load_dwordx4 v6, s[20:23], s44 offen offset:0 nt lds
    buffer_load_dwordx4 v7, s[20:23], s44 offen offset:1024 nt lds
    buffer_load_dwordx4 v8, s[20:23], s44 offen offset:2048 nt lds
    buffer_load_dwordx4 v9, s[20:23], s44 offen offset:3072 nt lds
    ds_read_b64_tr_b16 v[144:145], v14 offset:0
    ds_read_b64_tr_b16 v[146:147], v14 offset:8192
    ds_read_b64_tr_b16 v[148:149], v15 offset:0
    ds_read_b64_tr_b16 v[150:151], v15 offset:8192
    ds_read_b64_tr_b16 v[152:153], v14 offset:16384
    ds_read_b64_tr_b16 v[154:155], v14 offset:24576
    ds_read_b64_tr_b16 v[156:157], v15 offset:16384
    ds_read_b64_tr_b16 v[158:159], v15 offset:24576
    ds_read_b128 v[168:171], v18 offset:18432
    ds_read_b128 v[172:175], v18 offset:19456
    s_waitcnt lgkmcnt(8)
    v_mfma_f32_16x16x32_bf16 v[176:179], v[144:147], v[160:163], v[176:179]
    s_waitcnt lgkmcnt(6)
    v_mfma_f32_16x16x32_bf16 v[180:183], v[148:151], v[160:163], v[180:183]
    s_waitcnt lgkmcnt(4)
    v_mfma_f32_16x16x32_bf16 v[176:179], v[152:155], v[164:167], v[176:179]
    s_waitcnt lgkmcnt(2)
    v_mfma_f32_16x16x32_bf16 v[180:183], v[156:159], v[164:167], v[180:183]
    s_waitcnt vmcnt(5) lgkmcnt(0)
    s_barrier
    s_add_u32 m0, s43, 98304
    s_xor_b32 s44, s63, 360448
    buffer_load_dwordx4 v6, s[20:23], s44 offen offset:0 nt lds
    buffer_load_dwordx4 v7, s[20:23], s44 offen offset:1024 nt lds
    buffer_load_dwordx4 v8, s[20:23], s44 offen offset:2048 nt lds
    buffer_load_dwordx4 v9, s[20:23], s44 offen offset:3072 nt lds
    ds_read_b64_tr_b16 v[144:145], v16 offset:0
    ds_read_b64_tr_b16 v[146:147], v16 offset:8192
    ds_read_b64_tr_b16 v[148:149], v17 offset:0
    ds_read_b64_tr_b16 v[150:151], v17 offset:8192
    ds_read_b64_tr_b16 v[152:153], v16 offset:16384
    ds_read_b64_tr_b16 v[154:155], v16 offset:24576
    ds_read_b64_tr_b16 v[156:157], v17 offset:16384
    ds_read_b64_tr_b16 v[158:159], v17 offset:24576
    ds_read_b128 v[160:163], v18 offset:20480
    ds_read_b128 v[164:167], v18 offset:21504
    s_waitcnt lgkmcnt(8)
    v_mfma_f32_16x16x32_bf16 v[176:179], v[144:147], v[168:171], v[176:179]
    s_waitcnt lgkmcnt(6)
    v_mfma_f32_16x16x32_bf16 v[180:183], v[148:151], v[168:171], v[180:183]
    s_waitcnt lgkmcnt(4)
    v_mfma_f32_16x16x32_bf16 v[176:179], v[152:155], v[172:175], v[176:179]
    s_waitcnt lgkmcnt(2)
    v_mfma_f32_16x16x32_bf16 v[180:183], v[156:159], v[172:175], v[180:183]
    s_waitcnt vmcnt(4) lgkmcnt(0)
    s_barrier
    s_add_u32 m0, s43, 0
    s_xor_b32 s44, s63, 393216
    buffer_load_dwordx4 v6, s[20:23], s44 offen offset:0 nt lds
    buffer_load_dwordx4 v7, s[20:23], s44 offen offset:1024 nt lds
    buffer_load_dwordx4 v8, s[20:23], s44 offen offset:2048 nt lds
    buffer_load_dwordx4 v9, s[20:23], s44 offen offset:3072 nt lds
    ds_read_b64_tr_b16 v[144:145], v14 offset:32768
    ds_read_b64_tr_b16 v[146:147], v14 offset:40960
    ds_read_b64_tr_b16 v[148:149], v15 offset:32768
    ds_read_b64_tr_b16 v[150:151], v15 offset:40960
    ds_read_b64_tr_b16 v[152:153], v14 offset:49152
    ds_read_b64_tr_b16 v[154:155], v14 offset:57344
    ds_read_b64_tr_b16 v[156:157], v15 offset:49152
    ds_read_b64_tr_b16 v[158:159], v15 offset:57344
    ds_read_b128 v[168:171], v18 offset:22528
    ds_read_b128 v[172:175], v18 offset:23552
    s_waitcnt lgkmcnt(8)
    v_mfma_f32_16x16x32_bf16 v[176:179], v[144:147], v[160:163], v[176:179]
    s_waitcnt lgkmcnt(6)
    v_mfma_f32_16x16x32_bf16 v[180:183], v[148:151], v[160:163], v[180:183]
    s_waitcnt lgkmcnt(4)
    v_mfma_f32_16x16x32_bf16 v[176:179], v[152:155], v[164:167], v[176:179]
    s_waitcnt lgkmcnt(2)
    v_mfma_f32_16x16x32_bf16 v[180:183], v[156:159], v[164:167], v[180:183]
    v_xor_b32 v199, v199, v198
    s_nop 0
    v_readfirstlane_b32 s55, v199
    s_waitcnt vmcnt(4) lgkmcnt(0)
    s_barrier
    s_add_u32 m0, s43, 65536
    s_xor_b32 s44, s63, 425984
    buffer_load_dwordx4 v6, s[20:23], s44 offen offset:0 nt lds
    buffer_load_dwordx4 v7, s[20:23], s44 offen offset:1024 nt lds
    buffer_load_dwordx4 v8, s[20:23], s44 offen offset:2048 nt lds
    buffer_load_dwordx4 v9, s[20:23], s44 offen offset:3072 nt lds
    ds_read_b64_tr_b16 v[144:145], v16 offset:32768
    ds_read_b64_tr_b16 v[146:147], v16 offset:40960
    ds_read_b64_tr_b16 v[148:149], v17 offset:32768
    ds_read_b64_tr_b16 v[150:151], v17 offset:40960
    ds_read_b64_tr_b16 v[152:153], v16 offset:49152
    ds_read_b64_tr_b16 v[154:155], v16 offset:57344
    ds_read_b64_tr_b16 v[156:157], v17 offset:49152
    ds_read_b64_tr_b16 v[158:159], v17 offset:57344
    ds_read_b128 v[160:163], v18 offset:24576
    ds_read_b128 v[164:167], v18 offset:25600
    s_waitcnt lgkmcnt(8)
    v_mfma_f32_16x16x32_bf16 v[176:179], v[144:147], v[168:171], v[176:179]
    s_waitcnt lgkmcnt(6)
    v_mfma_f32_16x16x32_bf16 v[180:183], v[148:151], v[168:171], v[180:183]
    s_waitcnt lgkmcnt(4)
    v_mfma_f32_16x16x32_bf16 v[176:179], v[152:155], v[172:175], v[176:179]
    s_waitcnt lgkmcnt(2)
    v_mfma_f32_16x16x32_bf16 v[180:183], v[156:159], v[172:175], v[180:183]
    s_waitcnt vmcnt(4) lgkmcnt(0)
    s_barrier
    s_add_u32 m0, s43, 32768
    s_xor_b32 s44, s63, 458752
    buffer_load_dwordx4 v6, s[20:23], s44 offen offset:0 nt lds
    buffer_load_dwordx4 v7, s[20:23], s44 offen offset:1024 nt lds
    buffer_load_dwordx4 v8, s[20:23], s44 offen offset:2048 nt lds
    buffer_load_dwordx4 v9, s[20:23], s44 offen offset:3072 nt lds
    ds_read_b64_tr_b16 v[144:145], v14 offset:0
    ds_read_b64_tr_b16 v[146:147], v14 offset:8192
    ds_read_b64_tr_b16 v[148:149], v15 offset:0
    ds_read_b64_tr_b16 v[150:151], v15 offset:8192
    ds_read_b64_tr_b16 v[152:153], v14 offset:16384
    ds_read_b64_tr_b16 v[154:155], v14 offset:24576
    ds_read_b64_tr_b16 v[156:157], v15 offset:16384
    ds_read_b64_tr_b16 v[158:159], v15 offset:24576
    ds_read_b128 v[168:171], v18 offset:26624
    ds_read_b128 v[172:175], v18 offset:27648
    s_waitcnt lgkmcnt(8)
    v_mfma_f32_16x16x32_bf16 v[176:179], v[144:147], v[160:163], v[176:179]
    s_waitcnt lgkmcnt(6)
    v_mfma_f32_16x16x32_bf16 v[180:183], v[148:151], v[160:163], v[180:183]
    s_waitcnt lgkmcnt(4)
    v_mfma_f32_16x16x32_bf16 v[176:179], v[152:155], v[164:167], v[176:179]
    s_waitcnt lgkmcnt(2)
    v_mfma_f32_16x16x32_bf16 v[180:183], v[156:159], v[164:167], v[180:183]
    s_waitcnt vmcnt(4) lgkmcnt(0)
    s_barrier
    s_add_u32 m0, s43, 98304
    s_xor_b32 s44, s63, 491520
    buffer_load_dwordx4 v6, s[20:23], s44 offen offset:0 nt lds
    buffer_load_dwordx4 v7, s[20:23], s44 offen offset:1024 nt lds
    buffer_load_dwordx4 v8, s[20:23], s44 offen offset:2048 nt lds
    buffer_load_dwordx4 v9, s[20:23], s44 offen offset:3072 nt lds
    ds_read_b64_tr_b16 v[144:145], v16 offset:0
    ds_read_b64_tr_b16 v[146:147], v16 offset:8192
    ds_read_b64_tr_b16 v[148:149], v17 offset:0
    ds_read_b64_tr_b16 v[150:151], v17 offset:8192
    ds_read_b64_tr_b16 v[152:153], v16 offset:16384
    ds_read_b64_tr_b16 v[154:155], v16 offset:24576
    ds_read_b64_tr_b16 v[156:157], v17 offset:16384
    ds_read_b64_tr_b16 v[158:159], v17 offset:24576
    ds_read_b128 v[160:163], v18 offset:0
    ds_read_b128 v[164:167], v18 offset:1024
    s_waitcnt lgkmcnt(8)
    v_mfma_f32_16x16x32_bf16 v[176:179], v[144:147], v[168:171], v[176:179]
    s_waitcnt lgkmcnt(6)
    v_mfma_f32_16x16x32_bf16 v[180:183], v[148:151], v[168:171], v[180:183]
    s_waitcnt lgkmcnt(4)
    v_mfma_f32_16x16x32_bf16 v[176:179], v[152:155], v[172:175], v[176:179]
    s_waitcnt lgkmcnt(2)
    v_mfma_f32_16x16x32_bf16 v[180:183], v[156:159], v[172:175], v[180:183]
    s_waitcnt vmcnt(4) lgkmcnt(0)
    s_barrier
    ds_read_b64_tr_b16 v[144:145], v14 offset:32768
    ds_read_b64_tr_b16 v[146:147], v14 offset:40960
    ds_read_b64_tr_b16 v[148:149], v15 offset:32768
    ds_read_b64_tr_b16 v[150:151], v15 offset:40960
    ds_read_b64_tr_b16 v[152:153], v14 offset:49152
    ds_read_b64_tr_b16 v[154:155], v14 offset:57344
    ds_read_b64_tr_b16 v[156:157], v15 offset:49152
    ds_read_b64_tr_b16 v[158:159], v15 offset:57344
    ds_read_b128 v[168:171], v18 offset:2048
    ds_read_b128 v[172:175], v18 offset:3072
    s_waitcnt lgkmcnt(8)
    v_mfma_f32_16x16x32_bf16 v[176:179], v[144:147], v[160:163], v[176:179]
    s_waitcnt lgkmcnt(6)
    v_mfma_f32_16x16x32_bf16 v[180:183], v[148:151], v[160:163], v[180:183]
    s_waitcnt lgkmcnt(4)
    v_mfma_f32_16x16x32_bf16 v[176:179], v[152:155], v[164:167], v[176:179]
    s_waitcnt lgkmcnt(2)
    v_mfma_f32_16x16x32_bf16 v[180:183], v[156:159], v[164:167], v[180:183]
    s_cmp_eq_u32 s42, 1
    s_cbranch_scc1 L_merge
    s_waitcnt vmcnt(0) lgkmcnt(0)
    s_barrier
    ds_read_b64_tr_b16 v[144:145], v16 offset:32768
    ds_read_b64_tr_b16 v[146:147], v16 offset:40960
    ds_read_b64_tr_b16 v[148:149], v17 offset:32768
    ds_read_b64_tr_b16 v[150:151], v17 offset:40960
    ds_read_b64_tr_b16 v[152:153], v16 offset:49152
    ds_read_b64_tr_b16 v[154:155], v16 offset:57344
    ds_read_b64_tr_b16 v[156:157], v17 offset:49152
    ds_read_b64_tr_b16 v[158:159], v17 offset:57344
    s_waitcnt lgkmcnt(6)
    v_mfma_f32_16x16x32_bf16 v[176:179], v[144:147], v[168:171], v[176:179]
    s_waitcnt lgkmcnt(4)
    v_mfma_f32_16x16x32_bf16 v[180:183], v[148:151], v[168:171], v[180:183]
    s_waitcnt lgkmcnt(2)
    v_mfma_f32_16x16x32_bf16 v[176:179], v[152:155], v[172:175], v[176:179]
    s_waitcnt lgkmcnt(0)
    v_mfma_f32_16x16x32_bf16 v[180:183], v[156:159], v[172:175], v[180:183]
    s_nop 7
    v_mul_f32 v184, v176, v201
    v_mul_f32 v185, v177, v201
    v_mul_f32 v186, v178, v201
    v_mul_f32 v187, v179, v201
    v_mul_f32 v188, v180, v201
    v_mul_f32 v189, v181, v201
    v_mul_f32 v190, v182, v201
    v_mul_f32 v191, v183, v201
    v_bfi_b32 v184, 15, s68, v184
    v_bfi_b32 v185, 15, s69, v185
    v_bfi_b32 v186, 15, s70, v186
    v_bfi_b32 v187, 15, s71, v187
    v_bfi_b32 v188, 15, s68, v188
    v_bfi_b32 v189, 15, s69, v189
    v_bfi_b32 v190, 15, s70, v190
    v_bfi_b32 v191, 15, s71, v191
    s_cmp_lg_u32 s55, 0
    s_cbranch_scc1 L_far
    buffer_store_dwordx4 v[184:187], v202, s[32:35], s58 offen offset:0
    buffer_store_dwordx4 v[188:191], v202, s[32:35], s58 offen offset:1024
    buffer_store_dwordx2 v[192:193], v204, s[32:35], s58 offen offset:2048
    s_endpgm
L_far:
    buffer_store_dwordx4 v[184:187], v202, s[32:35], s58 offen offset:0 sc1
    buffer_store_dwordx4 v[188:191], v202, s[32:35], s58 offen offset:1024 sc1
    buffer_store_dwordx2 v[192:193], v204, s[32:35], s58 offen offset:2048 sc1
    s_endpgm
L_merge:
    buffer_load_dwordx4 v[184:187], v202, s[32:35], s58 offen offset:0 sc1
    buffer_load_dwordx4 v[188:191], v202, s[32:35], s58 offen offset:1024 sc1
    buffer_load_dwordx2 v[192:193], v204, s[32:35], s58 offen offset:2048 sc1
    s_waitcnt vmcnt(3) lgkmcnt(0)
    s_barrier
    ds_read_b64_tr_b16 v[144:145], v16 offset:32768
    ds_read_b64_tr_b16 v[146:147], v16 offset:40960
    ds_read_b64_tr_b16 v[148:149], v17 offset:32768
    ds_read_b64_tr_b16 v[150:151], v17 offset:40960
    ds_read_b64_tr_b16 v[152:153], v16 offset:49152
    ds_read_b64_tr_b16 v[154:155], v16 offset:57344
    ds_read_b64_tr_b16 v[156:157], v17 offset:49152
    ds_read_b64_tr_b16 v[158:159], v17 offset:57344
    s_waitcnt lgkmcnt(6)
    v_mfma_f32_16x16x32_bf16 v[176:179], v[144:147], v[168:171], v[176:179]
    s_waitcnt lgkmcnt(4)
    v_mfma_f32_16x16x32_bf16 v[180:183], v[148:151], v[168:171], v[180:183]
    s_waitcnt lgkmcnt(2)
    v_mfma_f32_16x16x32_bf16 v[176:179], v[152:155], v[172:175], v[176:179]
    s_waitcnt lgkmcnt(0)
    v_mfma_f32_16x16x32_bf16 v[180:183], v[156:159], v[172:175], v[180:183]
    s_mov_b32 s60, 0
L_chk:
    s_waitcnt vmcnt(0)
    v_xor_b32 v184, s68, v184
    v_xor_b32 v185, s69, v185
    v_xor_b32 v186, s70, v186
    v_xor_b32 v187, s71, v187
    v_xor_b32 v188, s68, v188
    v_xor_b32 v189, s69, v189
    v_xor_b32 v190, s70, v190
    v_xor_b32 v191, s71, v191
    v_xor_b32 v67, v193, v196
    v_or3_b32 v64, v184, v185, v186
    v_or3_b32 v65, v187, v188, v189
    v_or3_b32 v64, v64, v190, v191
    v_or_b32 v64, v64, v65
    v_and_or_b32 v64, v64, 15, v67
    v_cmp_ne_u32 vcc, 0, v64
    s_cbranch_vccnz L_wait
L_got:
    v_sub_f32 v22, v200, v192
    v_exp_f32 v22, v22
    s_nop 0
    v_add_f32 v22, 1.0, v22
    v_rcp_f32 v22, v22
    s_nop 0
    v_sub_f32 v23, 1.0, v22
    v_mul_f32 v23, v23, v201
    v_mul_f32 v184, v184, v22
    v_mul_f32 v185, v185, v22
    v_mul_f32 v186, v186, v22
    v_mul_f32 v187, v187, v22
    v_mul_f32 v188, v188, v22
    v_mul_f32 v189, v189, v22
    v_mul_f32 v190, v190, v22
    v_mul_f32 v191, v191, v22
    v_fmac_f32 v184, v176, v23
    v_fmac_f32 v185, v177, v23
    v_fmac_f32 v186, v178, v23
    v_fmac_f32 v187, v179, v23
    v_fmac_f32 v188, v180, v23
    v_fmac_f32 v189, v181, v23
    v_fmac_f32 v190, v182, v23
    v_fmac_f32 v191, v183, v23
    v_cvt_pk_bf16_f32 v24, v184, v185
    v_cvt_pk_bf16_f32 v25, v186, v187
    v_cvt_pk_bf16_f32 v26, v188, v189
    v_cvt_pk_bf16_f32 v27, v190, v191
    buffer_store_dwordx2 v[24:25], v203, s[28:31], s52 offen
    buffer_store_dwordx2 v[26:27], v203, s[28:31], s52 offen offset:32
    s_cmp_eq_u32 s61, 0
    s_cbranch_scc1 L_bdone
    s_mov_b64 exec, 1
    buffer_store_dword v196, v197, s[32:35], s59 offen offset:4
    s_mov_b64 exec, -1
L_bdone:
    s_endpgm
L_wait:
    s_add_u32 s60, s60, 1
    s_cmp_ge_u32 s60, 0x400000
    s_cbranch_scc1 L_got
    buffer_load_dwordx4 v[184:187], v202, s[32:35], s58 offen offset:0 sc1
    buffer_load_dwordx4 v[188:191], v202, s[32:35], s58 offen offset:1024 sc1
    buffer_load_dwordx2 v[192:193], v204, s[32:35], s58 offen offset:2048 sc1
    s_branch L_chk
L_end:
    s_endpgm
.section .rodata,"a"
.p2align 6
.amdhsa_kernel standalone__softmax_full_bidir__sampling_kernel
  .amdhsa_next_free_vgpr 216
  .amdhsa_next_free_sgpr 72
  .amdhsa_accum_offset 216
  .amdhsa_group_segment_fixed_size 0
  .amdhsa_kernarg_size 48
  .amdhsa_user_sgpr_count 2
  .amdhsa_user_sgpr_kernarg_segment_ptr 1
  .amdhsa_system_sgpr_workgroup_id_x 1
.end_amdhsa_kernel
```
